```python
import torch

def _softmax(x, axis=-1):
    return torch.softmax(x, dim=axis)
def _gelu(x):
    return torch.nn.functional.gelu(x, approximate="tanh")
def _silu(x):
    return torch.nn.functional.silu(x)
def _sigmoid(x):
    return torch.sigmoid(x)
def _layernorm(x, axis=-1, eps=1e-5):
    m = x.mean(dim=axis, keepdim=True)
    v = x.var(dim=axis, keepdim=True, unbiased=False)
    return (x - m) / torch.sqrt(v + eps)
def _scatter_add(tgt, idx, src, axis=0):
    return tgt.clone().index_add_(axis, idx, src)
def _segment_sum(src, seg, n):
    out = torch.zeros((n,) + src.shape[1:], dtype=src.dtype)
    return out.index_add_(0, seg, src)
def _pad(x, pw):
    flat = tuple(v for pair in reversed(pw) for v in pair)
    return torch.nn.functional.pad(x, flat)

kernel_name = 'standalone__gqa_softmax__decode'

def setup_inputs():

    _w = (lambda a: (lambda t: t.to(torch.bfloat16) if t.is_floating_point() else t)(torch.as_tensor(a)))
    B, Hq, Hkv, Sq, Sk, D = 4, 16, 8, 1, 16384, 256
    return {
        "q": _w((lambda *s: torch.randn(*s, dtype=torch.bfloat16) * 0.8)(B, Hq, Sq, D)),
        "k": _w((lambda *s: torch.randn(*s, dtype=torch.bfloat16) * 0.8)(B, Hkv, Sk, D)),
        "v": _w((lambda *s: torch.randn(*s, dtype=torch.bfloat16) * 0.05)(B, Hkv, Sk, D)),
    }

def reference(q, k, v):
    B, Hq, Sq, D = q.shape
    Hkv = k.shape[1]
    rep = Hq // Hkv
    k = (lambda x, n, axis: torch.repeat_interleave(x, n, dim=axis))(k, rep, axis=1)
    v = (lambda x, n, axis: torch.repeat_interleave(x, n, dim=axis))(v, rep, axis=1)
    scale = D ** -0.5
    scores = torch.einsum("bhqd,bhkd->bhqk", q, k) * scale
    p = _softmax(scores, axis=-1)
    return torch.einsum("bhqk,bhkd->bhqd", p, v)
```

```asm
; @launch grid=(192,1,1) block=(256,1,1) lds=87040
.amdgcn_target "amdgcn-amd-amdhsa--gfx950"
.text
.globl standalone__gqa_softmax__decode_kernel
.p2align 8
.type standalone__gqa_softmax__decode_kernel,@function
standalone__gqa_softmax__decode_kernel:
  s_cmp_ge_u32 s2, 192
  s_cbranch_scc1 L_end
  s_load_dwordx8 s[52:59], s[0:1], 0
  s_load_dwordx4 s[60:63], s[0:1], 32
  v_lshrrev_b32 v8, 6, v0
  v_and_b32 v1, 63, v0
  v_readfirstlane_b32 s28, v8
  v_lshlrev_b32 v2, 4, v1
  v_add_u32 v3, 4096, v2
  s_mov_b32 s36, 0x2aaaaaab
  s_mul_hi_u32 s29, s2, s36
  s_mul_i32 s36, s29, 6
  s_sub_u32 s30, s2, s36
  s_lshl_b32 s31, s29, 23
  s_mul_i32 s33, s28, 21760
  s_add_u32 s45, s28, s30
  s_and_b32 s45, s45, 3
  s_lshl_b32 s38, s29, 2
  s_add_u32 s38, s38, s45
  s_mul_i32 s38, s38, 256
  s_add_u32 s38, s38, 1048576
  s_mov_b32 s39, 0x3db8aa3b
  s_mov_b32 s40, 0
  s_mov_b32 s42, 2147483648
  s_mov_b32 s70, 0
  s_mov_b32 s46, 0x00030003
  s_mov_b32 s47, 0x00030003
  s_mul_i32 s43, s30, 152
  s_add_u32 s43, s43, s28
  s_lshl_b32 s43, s43, 13
  s_add_u32 s43, s43, s31
  s_mov_b32 s32, s43
  v_and_b32 v8, 15, v1
  v_lshrrev_b32 v9, 4, v1
  v_and_b32 v10, 7, v8
  v_mul_u32_u24 v4, 1040, v10
  v_lshrrev_b32 v10, 3, v8
  v_lshl_add_u32 v4, v10, 9, v4
  v_and_b32 v10, 1, v9
  v_lshlrev_b32 v11, 7, v10
  v_lshrrev_b32 v10, 1, v9
  v_lshl_add_u32 v11, v10, 8, v11
  v_add_u32 v4, v4, v11
  v_add_u32 v4, s33, v4
  v_and_b32 v10, 1, v8
  v_lshl_add_u32 v11, v10, 9, v11
  v_lshlrev_b32 v15, 6, v10
  v_lshl_add_u32 v15, v9, 4, v15
  v_add_u32 v15, s33, v15
  v_lshrrev_b32 v8, 2, v1
  v_and_b32 v10, 7, v8
  v_mul_u32_u24 v5, 1056, v10
  v_lshrrev_b32 v10, 3, v8
  v_lshl_add_u32 v5, v10, 9, v5
  v_and_b32 v10, 3, v1
  v_lshl_add_u32 v5, v10, 3, v5
  v_add_u32 v5, s33, v5
  v_mov_b32 v12, 0
  v_mov_b32 v6, 0xff7fffff
  v_mov_b32 v7, 0
  v_mov_b32 v13, 0
  v_mov_b32 v14, 0
  v_mov_b32 v16, 0
  s_waitcnt lgkmcnt(0)
  s_mov_b32 s4, s54
  s_mov_b32 s5, s55
  s_mov_b32 s6, 268435456
  s_mov_b32 s7, 0x20000
  s_mov_b32 s12, s62
  s_mov_b32 s13, s63
  s_mov_b32 s14, 1073741824
  s_mov_b32 s15, 0x20000
  s_cmp_lg_u32 s30, 0
  s_cbranch_scc1 L_noswap
  s_mov_b64 exec, 1
  buffer_atomic_swap v16, v12, s[12:15], s38 offen sc0
  s_mov_b64 exec, -1
L_noswap:
  s_add_u32 m0, s33, 0
  s_nop 0
  buffer_load_dwordx4 v2, s[4:7], s32 offen offset:0 nt lds
  s_add_u32 m0, s33, 16
  s_nop 0
  buffer_load_dwordx4 v2, s[4:7], s32 offen offset:1024 nt lds
  s_add_u32 m0, s33, 32
  s_nop 0
  buffer_load_dwordx4 v2, s[4:7], s32 offen offset:2048 nt lds
  s_add_u32 m0, s33, 48
  s_nop 0
  buffer_load_dwordx4 v2, s[4:7], s32 offen offset:3072 nt lds
  s_add_u32 m0, s33, 4160
  s_nop 0
  buffer_load_dwordx4 v3, s[4:7], s32 offen offset:0 nt lds
  s_add_u32 m0, s33, 4176
  s_nop 0
  buffer_load_dwordx4 v3, s[4:7], s32 offen offset:1024 nt lds
  s_add_u32 m0, s33, 4192
  s_nop 0
  buffer_load_dwordx4 v3, s[4:7], s32 offen offset:2048 nt lds
  s_add_u32 m0, s33, 4208
  s_nop 0
  buffer_load_dwordx4 v3, s[4:7], s32 offen offset:3072 nt lds
  s_mov_b32 s24, s52
  s_mov_b32 s25, s53
  s_mov_b32 s26, 32768
  s_mov_b32 s27, 0x20000
  s_lshl_b32 s36, s29, 10
  buffer_load_dwordx4 v[32:35], v11, s[24:27], s36 offen offset:0
  buffer_load_dwordx4 v[36:39], v11, s[24:27], s36 offen offset:16
  buffer_load_dwordx4 v[40:43], v11, s[24:27], s36 offen offset:32
  buffer_load_dwordx4 v[44:47], v11, s[24:27], s36 offen offset:48
  buffer_load_dwordx4 v[48:51], v11, s[24:27], s36 offen offset:64
  buffer_load_dwordx4 v[52:55], v11, s[24:27], s36 offen offset:80
  buffer_load_dwordx4 v[56:59], v11, s[24:27], s36 offen offset:96
  buffer_load_dwordx4 v[60:63], v11, s[24:27], s36 offen offset:112
  s_add_u32 s32, s32, 32768
  s_add_u32 m0, s33, 8448
  s_nop 0
  buffer_load_dwordx4 v2, s[4:7], s32 offen offset:0 nt lds
  s_add_u32 m0, s33, 8464
  s_nop 0
  buffer_load_dwordx4 v2, s[4:7], s32 offen offset:1024 nt lds
  s_add_u32 m0, s33, 8480
  s_nop 0
  buffer_load_dwordx4 v2, s[4:7], s32 offen offset:2048 nt lds
  s_add_u32 m0, s33, 8496
  s_nop 0
  buffer_load_dwordx4 v2, s[4:7], s32 offen offset:3072 nt lds
  s_add_u32 m0, s33, 12608
  s_nop 0
  buffer_load_dwordx4 v3, s[4:7], s32 offen offset:0 nt lds
  s_add_u32 m0, s33, 12624
  s_nop 0
  buffer_load_dwordx4 v3, s[4:7], s32 offen offset:1024 nt lds
  s_add_u32 m0, s33, 12640
  s_nop 0
  buffer_load_dwordx4 v3, s[4:7], s32 offen offset:2048 nt lds
  s_add_u32 m0, s33, 12656
  s_nop 0
  buffer_load_dwordx4 v3, s[4:7], s32 offen offset:3072 nt lds
  s_mov_b32 s8, s56
  s_mov_b32 s9, s57
  s_mov_b32 s10, 268435456
  s_mov_b32 s11, 0x20000
  s_mov_b32 s20, s58
  s_mov_b32 s21, s59
  s_mov_b32 s22, 32768
  s_mov_b32 s23, 0x20000
  s_mov_b32 s16, s60
  s_mov_b32 s17, s61
  s_mov_b32 s18, 256
  s_mov_b32 s19, 0x20000
  v_mov_b32 v128, 0
  v_mov_b32 v129, 0
  v_mov_b32 v130, 0
  v_mov_b32 v131, 0
  v_mov_b32 v132, 0
  v_mov_b32 v133, 0
  v_mov_b32 v134, 0
  v_mov_b32 v135, 0
  v_mov_b32 v136, 0
  v_mov_b32 v137, 0
  v_mov_b32 v138, 0
  v_mov_b32 v139, 0
  v_mov_b32 v140, 0
  v_mov_b32 v141, 0
  v_mov_b32 v142, 0
  v_mov_b32 v143, 0
  v_mov_b32 v144, 0
  v_mov_b32 v145, 0
  v_mov_b32 v146, 0
  v_mov_b32 v147, 0
  v_mov_b32 v148, 0
  v_mov_b32 v149, 0
  v_mov_b32 v150, 0
  v_mov_b32 v151, 0
  v_mov_b32 v152, 0
  v_mov_b32 v153, 0
  v_mov_b32 v154, 0
  v_mov_b32 v155, 0
  v_mov_b32 v156, 0
  v_mov_b32 v157, 0
  v_mov_b32 v158, 0
  v_mov_b32 v159, 0
  v_mov_b32 v160, 0
  v_mov_b32 v161, 0
  v_mov_b32 v162, 0
  v_mov_b32 v163, 0
  v_mov_b32 v164, 0
  v_mov_b32 v165, 0
  v_mov_b32 v166, 0
  v_mov_b32 v167, 0
  v_mov_b32 v168, 0
  v_mov_b32 v169, 0
  v_mov_b32 v170, 0
  v_mov_b32 v171, 0
  v_mov_b32 v172, 0
  v_mov_b32 v173, 0
  v_mov_b32 v174, 0
  v_mov_b32 v175, 0
  v_mov_b32 v176, 0
  v_mov_b32 v177, 0
  v_mov_b32 v178, 0
  v_mov_b32 v179, 0
  v_mov_b32 v180, 0
  v_mov_b32 v181, 0
  v_mov_b32 v182, 0
  v_mov_b32 v183, 0
  v_mov_b32 v184, 0
  v_mov_b32 v185, 0
  v_mov_b32 v186, 0
  v_mov_b32 v187, 0
  v_mov_b32 v188, 0
  v_mov_b32 v189, 0
  v_mov_b32 v190, 0
  v_mov_b32 v191, 0
  s_mov_b32 s34, 0
  s_cmp_lg_u32 s30, 0
  s_cbranch_scc1 L_noinit
  s_lshl_b32 s36, 1, s45
  v_mov_b32 v8, s36
  s_lshl_b32 s36, s29, 2
  s_waitcnt vmcnt(8)
  s_mov_b64 exec, 1
  buffer_atomic_or v8, v12, s[16:19], s36 offen
  s_mov_b64 exec, -1
L_noinit:
  s_mov_b32 s44, 18
L_A:
  s_waitcnt vmcnt(8)
  ds_read_b128 v[64:67], v4 offset:0
  ds_read_b128 v[68:71], v4 offset:16
  ds_read_b128 v[72:75], v4 offset:32
  ds_read_b128 v[76:79], v4 offset:48
  ds_read_b128 v[80:83], v4 offset:64
  ds_read_b128 v[84:87], v4 offset:80
  ds_read_b128 v[88:91], v4 offset:96
  ds_read_b128 v[92:95], v4 offset:112
  s_add_u32 s32, s32, 32768
  s_waitcnt lgkmcnt(0)
  s_add_u32 m0, s33, 0
  v_mfma_f32_16x16x32_bf16 v[20:23], v[64:67], v[32:35], 0
  buffer_load_dwordx4 v2, s[4:7], s32 offen offset:0 nt lds
  s_add_u32 m0, s33, 16
  v_mfma_f32_16x16x32_bf16 v[20:23], v[68:71], v[36:39], v[20:23]
  buffer_load_dwordx4 v2, s[4:7], s32 offen offset:1024 nt lds
  s_add_u32 m0, s33, 32
  v_mfma_f32_16x16x32_bf16 v[20:23], v[72:75], v[40:43], v[20:23]
  buffer_load_dwordx4 v2, s[4:7], s32 offen offset:2048 nt lds
  s_add_u32 m0, s33, 48
  v_mfma_f32_16x16x32_bf16 v[20:23], v[76:79], v[44:47], v[20:23]
  buffer_load_dwordx4 v2, s[4:7], s32 offen offset:3072 nt lds
  s_add_u32 m0, s33, 4160
  v_mfma_f32_16x16x32_bf16 v[20:23], v[80:83], v[48:51], v[20:23]
  buffer_load_dwordx4 v3, s[4:7], s32 offen offset:0 nt lds
  s_add_u32 m0, s33, 4176
  v_mfma_f32_16x16x32_bf16 v[20:23], v[84:87], v[52:55], v[20:23]
  buffer_load_dwordx4 v3, s[4:7], s32 offen offset:1024 nt lds
  s_add_u32 m0, s33, 4192
  v_mfma_f32_16x16x32_bf16 v[20:23], v[88:91], v[56:59], v[20:23]
  buffer_load_dwordx4 v3, s[4:7], s32 offen offset:2048 nt lds
  s_add_u32 m0, s33, 4208
  v_mfma_f32_16x16x32_bf16 v[20:23], v[92:95], v[60:63], v[20:23]
  buffer_load_dwordx4 v3, s[4:7], s32 offen offset:3072 nt lds
  s_nop 7
  v_max3_f32 v6, v20, v21, v6
  v_max3_f32 v6, v22, v23, v6
  s_mov_b64 exec, s[46:47]
  ds_write_b128 v15, v[20:23] offset:16896
  s_mov_b64 exec, -1
  s_add_u32 s34, s34, 1
  s_waitcnt vmcnt(8)
  ds_read_b128 v[64:67], v4 offset:8448
  ds_read_b128 v[68:71], v4 offset:8464
  ds_read_b128 v[72:75], v4 offset:8480
  ds_read_b128 v[76:79], v4 offset:8496
  ds_read_b128 v[80:83], v4 offset:8512
  ds_read_b128 v[84:87], v4 offset:8528
  ds_read_b128 v[88:91], v4 offset:8544
  ds_read_b128 v[92:95], v4 offset:8560
  s_add_u32 s32, s32, 32768
  s_waitcnt lgkmcnt(0)
  s_add_u32 m0, s33, 8448
  v_mfma_f32_16x16x32_bf16 v[20:23], v[64:67], v[32:35], 0
  buffer_load_dwordx4 v2, s[4:7], s32 offen offset:0 nt lds
  s_add_u32 m0, s33, 8464
  v_mfma_f32_16x16x32_bf16 v[20:23], v[68:71], v[36:39], v[20:23]
  buffer_load_dwordx4 v2, s[4:7], s32 offen offset:1024 nt lds
  s_add_u32 m0, s33, 8480
  v_mfma_f32_16x16x32_bf16 v[20:23], v[72:75], v[40:43], v[20:23]
  buffer_load_dwordx4 v2, s[4:7], s32 offen offset:2048 nt lds
  s_add_u32 m0, s33, 8496
  v_mfma_f32_16x16x32_bf16 v[20:23], v[76:79], v[44:47], v[20:23]
  buffer_load_dwordx4 v2, s[4:7], s32 offen offset:3072 nt lds
  s_add_u32 m0, s33, 12608
  v_mfma_f32_16x16x32_bf16 v[20:23], v[80:83], v[48:51], v[20:23]
  buffer_load_dwordx4 v3, s[4:7], s32 offen offset:0 nt lds
  s_add_u32 m0, s33, 12624
  v_mfma_f32_16x16x32_bf16 v[20:23], v[84:87], v[52:55], v[20:23]
  buffer_load_dwordx4 v3, s[4:7], s32 offen offset:1024 nt lds
  s_add_u32 m0, s33, 12640
  v_mfma_f32_16x16x32_bf16 v[20:23], v[88:91], v[56:59], v[20:23]
  buffer_load_dwordx4 v3, s[4:7], s32 offen offset:2048 nt lds
  s_add_u32 m0, s33, 12656
  v_mfma_f32_16x16x32_bf16 v[20:23], v[92:95], v[60:63], v[20:23]
  buffer_load_dwordx4 v3, s[4:7], s32 offen offset:3072 nt lds
  s_nop 7
  v_max3_f32 v6, v20, v21, v6
  v_max3_f32 v6, v22, v23, v6
  s_mov_b64 exec, s[46:47]
  ds_write_b128 v15, v[20:23] offset:17024
  s_mov_b64 exec, -1
  v_add_u32 v15, 256, v15
  s_add_u32 s34, s34, 1
  s_sub_u32 s44, s44, 1
  s_cmp_lg_u32 s44, 0
  s_cbranch_scc1 L_A
  s_waitcnt vmcnt(8)
  ds_read_b128 v[64:67], v4 offset:0
  ds_read_b128 v[68:71], v4 offset:16
  ds_read_b128 v[72:75], v4 offset:32
  ds_read_b128 v[76:79], v4 offset:48
  ds_read_b128 v[80:83], v4 offset:64
  ds_read_b128 v[84:87], v4 offset:80
  ds_read_b128 v[88:91], v4 offset:96
  ds_read_b128 v[92:95], v4 offset:112
  s_mov_b32 s32, s43
  s_waitcnt lgkmcnt(0)
  s_add_u32 m0, s33, 0
  v_mfma_f32_16x16x32_bf16 v[20:23], v[64:67], v[32:35], 0
  buffer_load_dwordx4 v2, s[8:11], s32 offen offset:0 nt lds
  s_add_u32 m0, s33, 32
  v_mfma_f32_16x16x32_bf16 v[20:23], v[68:71], v[36:39], v[20:23]
  buffer_load_dwordx4 v2, s[8:11], s32 offen offset:1024 nt lds
  s_add_u32 m0, s33, 64
  v_mfma_f32_16x16x32_bf16 v[20:23], v[72:75], v[40:43], v[20:23]
  buffer_load_dwordx4 v2, s[8:11], s32 offen offset:2048 nt lds
  s_add_u32 m0, s33, 96
  v_mfma_f32_16x16x32_bf16 v[20:23], v[76:79], v[44:47], v[20:23]
  buffer_load_dwordx4 v2, s[8:11], s32 offen offset:3072 nt lds
  s_add_u32 m0, s33, 4224
  v_mfma_f32_16x16x32_bf16 v[20:23], v[80:83], v[48:51], v[20:23]
  buffer_load_dwordx4 v3, s[8:11], s32 offen offset:0 nt lds
  s_add_u32 m0, s33, 4256
  v_mfma_f32_16x16x32_bf16 v[20:23], v[84:87], v[52:55], v[20:23]
  buffer_load_dwordx4 v3, s[8:11], s32 offen offset:1024 nt lds
  s_add_u32 m0, s33, 4288
  v_mfma_f32_16x16x32_bf16 v[20:23], v[88:91], v[56:59], v[20:23]
  buffer_load_dwordx4 v3, s[8:11], s32 offen offset:2048 nt lds
  s_add_u32 m0, s33, 4320
  v_mfma_f32_16x16x32_bf16 v[20:23], v[92:95], v[60:63], v[20:23]
  buffer_load_dwordx4 v3, s[8:11], s32 offen offset:3072 nt lds
  s_lshl_b32 s36, s29, 2
  buffer_load_dword v13, v12, s[16:19], s36 offen sc1
  s_nop 7
  v_max3_f32 v6, v20, v21, v6
  v_max3_f32 v6, v22, v23, v6
  s_mov_b64 exec, s[46:47]
  ds_write_b128 v15, v[20:23] offset:16896
  s_mov_b64 exec, -1
  s_add_u32 s34, s34, 1
  s_waitcnt vmcnt(8)
  ds_read_b128 v[64:67], v4 offset:8448
  ds_read_b128 v[68:71], v4 offset:8464
  ds_read_b128 v[72:75], v4 offset:8480
  ds_read_b128 v[76:79], v4 offset:8496
  ds_read_b128 v[80:83], v4 offset:8512
  ds_read_b128 v[84:87], v4 offset:8528
  ds_read_b128 v[88:91], v4 offset:8544
  ds_read_b128 v[92:95], v4 offset:8560
  s_add_u32 s32, s32, 32768
  s_waitcnt lgkmcnt(0)
  s_add_u32 m0, s33, 8448
  v_mfma_f32_16x16x32_bf16 v[20:23], v[64:67], v[32:35], 0
  buffer_load_dwordx4 v2, s[8:11], s32 offen offset:0 nt lds
  s_add_u32 m0, s33, 8480
  v_mfma_f32_16x16x32_bf16 v[20:23], v[68:71], v[36:39], v[20:23]
  buffer_load_dwordx4 v2, s[8:11], s32 offen offset:1024 nt lds
  s_add_u32 m0, s33, 8512
  v_mfma_f32_16x16x32_bf16 v[20:23], v[72:75], v[40:43], v[20:23]
  buffer_load_dwordx4 v2, s[8:11], s32 offen offset:2048 nt lds
  s_add_u32 m0, s33, 8544
  v_mfma_f32_16x16x32_bf16 v[20:23], v[76:79], v[44:47], v[20:23]
  buffer_load_dwordx4 v2, s[8:11], s32 offen offset:3072 nt lds
  s_add_u32 m0, s33, 12672
  v_mfma_f32_16x16x32_bf16 v[20:23], v[80:83], v[48:51], v[20:23]
  buffer_load_dwordx4 v3, s[8:11], s32 offen offset:0 nt lds
  s_add_u32 m0, s33, 12704
  v_mfma_f32_16x16x32_bf16 v[20:23], v[84:87], v[52:55], v[20:23]
  buffer_load_dwordx4 v3, s[8:11], s32 offen offset:1024 nt lds
  s_add_u32 m0, s33, 12736
  v_mfma_f32_16x16x32_bf16 v[20:23], v[88:91], v[56:59], v[20:23]
  buffer_load_dwordx4 v3, s[8:11], s32 offen offset:2048 nt lds
  s_add_u32 m0, s33, 12768
  v_mfma_f32_16x16x32_bf16 v[20:23], v[92:95], v[60:63], v[20:23]
  buffer_load_dwordx4 v3, s[8:11], s32 offen offset:3072 nt lds
  s_nop 7
  v_max3_f32 v6, v20, v21, v6
  v_max3_f32 v6, v22, v23, v6
  s_mov_b64 exec, s[46:47]
  ds_write_b128 v15, v[20:23] offset:17024
  s_mov_b64 exec, -1
  v_add_u32 v15, 256, v15
  s_add_u32 s34, s34, 1
  v_mov_b32 v9, v6
  v_subrev_u32 v15, 4864, v15
  s_nop 0
  v_permlane32_swap_b32 v6, v9
  v_max_f32 v6, v6, v9
  v_mov_b32 v9, v6
  s_nop 1
  v_permlane16_swap_b32 v6, v9
  v_max_f32 v6, v6, v9
  v_mul_f32 v6, s39, v6
  s_mov_b32 s44, 18
L_B:
  ds_read_b128 v[20:23], v15 offset:16896
  s_waitcnt lgkmcnt(0)
  v_fma_f32 v28, v20, s39, -v6
  v_fma_f32 v29, v21, s39, -v6
  v_fma_f32 v30, v22, s39, -v6
  v_fma_f32 v31, v23, s39, -v6
  v_exp_f32 v28, v28
  v_exp_f32 v29, v29
  v_exp_f32 v30, v30
  v_exp_f32 v31, v31
  s_nop 0
  v_cvt_pk_bf16_f32 v24, v28, v29
  v_cvt_pk_bf16_f32 v25, v30, v31
  v_add_f32 v8, v28, v29
  v_add_f32 v9, v30, v31
  v_add_f32 v8, v8, v9
  v_add_f32 v7, v7, v8
  s_waitcnt vmcnt(8)
  ds_read_b64_tr_b16 v[96:97], v5 offset:0
  ds_read_b64_tr_b16 v[98:99], v5 offset:32
  ds_read_b64_tr_b16 v[100:101], v5 offset:64
  ds_read_b64_tr_b16 v[102:103], v5 offset:96
  ds_read_b64_tr_b16 v[104:105], v5 offset:128
  ds_read_b64_tr_b16 v[106:107], v5 offset:160
  ds_read_b64_tr_b16 v[108:109], v5 offset:192
  ds_read_b64_tr_b16 v[110:111], v5 offset:224
  ds_read_b64_tr_b16 v[112:113], v5 offset:256
  ds_read_b64_tr_b16 v[114:115], v5 offset:288
  ds_read_b64_tr_b16 v[116:117], v5 offset:320
  ds_read_b64_tr_b16 v[118:119], v5 offset:352
  ds_read_b64_tr_b16 v[120:121], v5 offset:384
  ds_read_b64_tr_b16 v[122:123], v5 offset:416
  ds_read_b64_tr_b16 v[124:125], v5 offset:448
  ds_read_b64_tr_b16 v[126:127], v5 offset:480
  s_add_u32 s32, s32, 32768
  s_waitcnt lgkmcnt(0)
  s_add_u32 m0, s33, 0
  v_mfma_f32_16x16x16_bf16 v[128:131], v[96:97], v[24:25], v[128:131]
  buffer_load_dwordx4 v2, s[8:11], s32 offen offset:0 nt lds
  s_add_u32 m0, s33, 32
  v_mfma_f32_16x16x16_bf16 v[132:135], v[98:99], v[24:25], v[132:135]
  buffer_load_dwordx4 v2, s[8:11], s32 offen offset:1024 nt lds
  s_add_u32 m0, s33, 64
  v_mfma_f32_16x16x16_bf16 v[136:139], v[100:101], v[24:25], v[136:139]
  buffer_load_dwordx4 v2, s[8:11], s32 offen offset:2048 nt lds
  s_add_u32 m0, s33, 96
  v_mfma_f32_16x16x16_bf16 v[140:143], v[102:103], v[24:25], v[140:143]
  buffer_load_dwordx4 v2, s[8:11], s32 offen offset:3072 nt lds
  s_add_u32 m0, s33, 4224
  v_mfma_f32_16x16x16_bf16 v[144:147], v[104:105], v[24:25], v[144:147]
  buffer_load_dwordx4 v3, s[8:11], s32 offen offset:0 nt lds
  s_add_u32 m0, s33, 4256
  v_mfma_f32_16x16x16_bf16 v[148:151], v[106:107], v[24:25], v[148:151]
  buffer_load_dwordx4 v3, s[8:11], s32 offen offset:1024 nt lds
  s_add_u32 m0, s33, 4288
  v_mfma_f32_16x16x16_bf16 v[152:155], v[108:109], v[24:25], v[152:155]
  buffer_load_dwordx4 v3, s[8:11], s32 offen offset:2048 nt lds
  s_add_u32 m0, s33, 4320
  v_mfma_f32_16x16x16_bf16 v[156:159], v[110:111], v[24:25], v[156:159]
  buffer_load_dwordx4 v3, s[8:11], s32 offen offset:3072 nt lds
  v_mfma_f32_16x16x16_bf16 v[160:163], v[112:113], v[24:25], v[160:163]
  v_mfma_f32_16x16x16_bf16 v[164:167], v[114:115], v[24:25], v[164:167]
  v_mfma_f32_16x16x16_bf16 v[168:171], v[116:117], v[24:25], v[168:171]
  v_mfma_f32_16x16x16_bf16 v[172:175], v[118:119], v[24:25], v[172:175]
  v_mfma_f32_16x16x16_bf16 v[176:179], v[120:121], v[24:25], v[176:179]
  v_mfma_f32_16x16x16_bf16 v[180:183], v[122:123], v[24:25], v[180:183]
  v_mfma_f32_16x16x16_bf16 v[184:187], v[124:125], v[24:25], v[184:187]
  v_mfma_f32_16x16x16_bf16 v[188:191], v[126:127], v[24:25], v[188:191]
  s_cmp_lg_u32 s44, 17
  s_cbranch_scc1 L_noflag
L_flagchk:
  v_readfirstlane_b32 s36, v13
  s_lshr_b32 s36, s36, s45
  s_and_b32 s36, s36, 1
  s_cmp_eq_u32 s30, 0
  s_cselect_b32 s36, 1, s36
  s_cmp_eq_u32 s36, 0
  s_cselect_b32 s40, 0x40000000, 0
L_noflag:
  s_cmp_lg_u32 s44, 1
  s_cbranch_scc1 L_nograb
  s_cmp_lg_u32 s40, 0
  s_cbranch_scc1 L_dumF
  v_mov_b32 v14, 1
  s_mov_b64 exec, 1
  buffer_atomic_add v14, v12, s[12:15], s38 offen sc0
  s_mov_b64 exec, -1
  s_branch L_xF
L_dumF:
  buffer_load_dword v16, v12, s[16:19], s42 offen
L_xF:
L_nograb:
  s_add_u32 s34, s34, 1
  ds_read_b128 v[20:23], v15 offset:17024
  s_waitcnt lgkmcnt(0)
  v_fma_f32 v28, v20, s39, -v6
  v_fma_f32 v29, v21, s39, -v6
  v_fma_f32 v30, v22, s39, -v6
  v_fma_f32 v31, v23, s39, -v6
  v_exp_f32 v28, v28
  v_exp_f32 v29, v29
  v_exp_f32 v30, v30
  v_exp_f32 v31, v31
  s_nop 0
  v_cvt_pk_bf16_f32 v24, v28, v29
  v_cvt_pk_bf16_f32 v25, v30, v31
  v_add_f32 v8, v28, v29
  v_add_f32 v9, v30, v31
  v_add_f32 v8, v8, v9
  v_add_f32 v7, v7, v8
  s_waitcnt vmcnt(8)
  ds_read_b64_tr_b16 v[96:97], v5 offset:8448
  ds_read_b64_tr_b16 v[98:99], v5 offset:8480
  ds_read_b64_tr_b16 v[100:101], v5 offset:8512
  ds_read_b64_tr_b16 v[102:103], v5 offset:8544
  ds_read_b64_tr_b16 v[104:105], v5 offset:8576
  ds_read_b64_tr_b16 v[106:107], v5 offset:8608
  ds_read_b64_tr_b16 v[108:109], v5 offset:8640
  ds_read_b64_tr_b16 v[110:111], v5 offset:8672
  ds_read_b64_tr_b16 v[112:113], v5 offset:8704
  ds_read_b64_tr_b16 v[114:115], v5 offset:8736
  ds_read_b64_tr_b16 v[116:117], v5 offset:8768
  ds_read_b64_tr_b16 v[118:119], v5 offset:8800
  ds_read_b64_tr_b16 v[120:121], v5 offset:8832
  ds_read_b64_tr_b16 v[122:123], v5 offset:8864
  ds_read_b64_tr_b16 v[124:125], v5 offset:8896
  ds_read_b64_tr_b16 v[126:127], v5 offset:8928
  s_add_u32 s32, s32, 32768
  s_waitcnt lgkmcnt(0)
  s_add_u32 m0, s33, 8448
  v_mfma_f32_16x16x16_bf16 v[128:131], v[96:97], v[24:25], v[128:131]
  buffer_load_dwordx4 v2, s[8:11], s32 offen offset:0 nt lds
  s_add_u32 m0, s33, 8480
  v_mfma_f32_16x16x16_bf16 v[132:135], v[98:99], v[24:25], v[132:135]
  buffer_load_dwordx4 v2, s[8:11], s32 offen offset:1024 nt lds
  s_add_u32 m0, s33, 8512
  v_mfma_f32_16x16x16_bf16 v[136:139], v[100:101], v[24:25], v[136:139]
  buffer_load_dwordx4 v2, s[8:11], s32 offen offset:2048 nt lds
  s_add_u32 m0, s33, 8544
  v_mfma_f32_16x16x16_bf16 v[140:143], v[102:103], v[24:25], v[140:143]
  buffer_load_dwordx4 v2, s[8:11], s32 offen offset:3072 nt lds
  s_add_u32 m0, s33, 12672
  v_mfma_f32_16x16x16_bf16 v[144:147], v[104:105], v[24:25], v[144:147]
  buffer_load_dwordx4 v3, s[8:11], s32 offen offset:0 nt lds
  s_add_u32 m0, s33, 12704
  v_mfma_f32_16x16x16_bf16 v[148:151], v[106:107], v[24:25], v[148:151]
  buffer_load_dwordx4 v3, s[8:11], s32 offen offset:1024 nt lds
  s_add_u32 m0, s33, 12736
  v_mfma_f32_16x16x16_bf16 v[152:155], v[108:109], v[24:25], v[152:155]
  buffer_load_dwordx4 v3, s[8:11], s32 offen offset:2048 nt lds
  s_add_u32 m0, s33, 12768
  v_mfma_f32_16x16x16_bf16 v[156:159], v[110:111], v[24:25], v[156:159]
  buffer_load_dwordx4 v3, s[8:11], s32 offen offset:3072 nt lds
  v_mfma_f32_16x16x16_bf16 v[160:163], v[112:113], v[24:25], v[160:163]
  v_mfma_f32_16x16x16_bf16 v[164:167], v[114:115], v[24:25], v[164:167]
  v_mfma_f32_16x16x16_bf16 v[168:171], v[116:117], v[24:25], v[168:171]
  v_mfma_f32_16x16x16_bf16 v[172:175], v[118:119], v[24:25], v[172:175]
  v_mfma_f32_16x16x16_bf16 v[176:179], v[120:121], v[24:25], v[176:179]
  v_mfma_f32_16x16x16_bf16 v[180:183], v[122:123], v[24:25], v[180:183]
  v_mfma_f32_16x16x16_bf16 v[184:187], v[124:125], v[24:25], v[184:187]
  v_mfma_f32_16x16x16_bf16 v[188:191], v[126:127], v[24:25], v[188:191]
  v_add_u32 v15, 256, v15
  s_add_u32 s34, s34, 1
  s_sub_u32 s44, s44, 1
  s_cmp_lg_u32 s44, 0
  s_cbranch_scc1 L_B
  ds_read_b128 v[20:23], v15 offset:16896
  s_waitcnt lgkmcnt(0)
  v_fma_f32 v28, v20, s39, -v6
  v_fma_f32 v29, v21, s39, -v6
  v_fma_f32 v30, v22, s39, -v6
  v_fma_f32 v31, v23, s39, -v6
  v_exp_f32 v28, v28
  v_exp_f32 v29, v29
  v_exp_f32 v30, v30
  v_exp_f32 v31, v31
  s_nop 0
  v_cvt_pk_bf16_f32 v24, v28, v29
  v_cvt_pk_bf16_f32 v25, v30, v31
  v_add_f32 v8, v28, v29
  v_add_f32 v9, v30, v31
  v_add_f32 v8, v8, v9
  v_add_f32 v7, v7, v8
  s_waitcnt vmcnt(8)
  ds_read_b64_tr_b16 v[96:97], v5 offset:0
  ds_read_b64_tr_b16 v[98:99], v5 offset:32
  ds_read_b64_tr_b16 v[100:101], v5 offset:64
  ds_read_b64_tr_b16 v[102:103], v5 offset:96
  ds_read_b64_tr_b16 v[104:105], v5 offset:128
  ds_read_b64_tr_b16 v[106:107], v5 offset:160
  ds_read_b64_tr_b16 v[108:109], v5 offset:192
  ds_read_b64_tr_b16 v[110:111], v5 offset:224
  ds_read_b64_tr_b16 v[112:113], v5 offset:256
  ds_read_b64_tr_b16 v[114:115], v5 offset:288
  ds_read_b64_tr_b16 v[116:117], v5 offset:320
  ds_read_b64_tr_b16 v[118:119], v5 offset:352
  ds_read_b64_tr_b16 v[120:121], v5 offset:384
  ds_read_b64_tr_b16 v[122:123], v5 offset:416
  ds_read_b64_tr_b16 v[124:125], v5 offset:448
  ds_read_b64_tr_b16 v[126:127], v5 offset:480
  v_readfirstlane_b32 s35, v14
  s_lshl_b32 s35, s35, 2
  s_add_u32 s35, s35, s45
  s_add_u32 s35, s35, 912
  s_or_b32 s35, s35, s40
  s_lshl_b32 s32, s35, 13
  s_add_u32 s32, s32, s31
  s_cmp_lt_u32 s35, 1024
  s_cselect_b32 s32, s32, s42
  s_cselect_b32 s41, 1, 0
  s_cselect_b32 s40, s40, 0x40000000
  s_waitcnt lgkmcnt(0)
  s_cmp_lg_u32 s40, 0
  s_cbranch_scc1 L_dumB
  v_mov_b32 v14, 1
  s_mov_b64 exec, 1
  buffer_atomic_add v14, v12, s[12:15], s38 offen sc0
  s_mov_b64 exec, -1
  s_branch L_xB
L_dumB:
  buffer_load_dword v16, v12, s[16:19], s42 offen
L_xB:
  s_add_u32 m0, s33, 0
  v_mfma_f32_16x16x16_bf16 v[128:131], v[96:97], v[24:25], v[128:131]
  buffer_load_dwordx4 v2, s[4:7], s32 offen offset:0 nt lds
  s_add_u32 m0, s33, 16
  v_mfma_f32_16x16x16_bf16 v[132:135], v[98:99], v[24:25], v[132:135]
  buffer_load_dwordx4 v2, s[4:7], s32 offen offset:1024 nt lds
  s_add_u32 m0, s33, 32
  v_mfma_f32_16x16x16_bf16 v[136:139], v[100:101], v[24:25], v[136:139]
  buffer_load_dwordx4 v2, s[4:7], s32 offen offset:2048 nt lds
  s_add_u32 m0, s33, 48
  v_mfma_f32_16x16x16_bf16 v[140:143], v[102:103], v[24:25], v[140:143]
  buffer_load_dwordx4 v2, s[4:7], s32 offen offset:3072 nt lds
  s_add_u32 m0, s33, 4160
  v_mfma_f32_16x16x16_bf16 v[144:147], v[104:105], v[24:25], v[144:147]
  buffer_load_dwordx4 v3, s[4:7], s32 offen offset:0 nt lds
  s_add_u32 m0, s33, 4176
  v_mfma_f32_16x16x16_bf16 v[148:151], v[106:107], v[24:25], v[148:151]
  buffer_load_dwordx4 v3, s[4:7], s32 offen offset:1024 nt lds
  s_add_u32 m0, s33, 4192
  v_mfma_f32_16x16x16_bf16 v[152:155], v[108:109], v[24:25], v[152:155]
  buffer_load_dwordx4 v3, s[4:7], s32 offen offset:2048 nt lds
  s_add_u32 m0, s33, 4208
  v_mfma_f32_16x16x16_bf16 v[156:159], v[110:111], v[24:25], v[156:159]
  buffer_load_dwordx4 v3, s[4:7], s32 offen offset:3072 nt lds
  v_mfma_f32_16x16x16_bf16 v[160:163], v[112:113], v[24:25], v[160:163]
  v_mfma_f32_16x16x16_bf16 v[164:167], v[114:115], v[24:25], v[164:167]
  v_mfma_f32_16x16x16_bf16 v[168:171], v[116:117], v[24:25], v[168:171]
  v_mfma_f32_16x16x16_bf16 v[172:175], v[118:119], v[24:25], v[172:175]
  v_mfma_f32_16x16x16_bf16 v[176:179], v[120:121], v[24:25], v[176:179]
  v_mfma_f32_16x16x16_bf16 v[180:183], v[122:123], v[24:25], v[180:183]
  v_mfma_f32_16x16x16_bf16 v[184:187], v[124:125], v[24:25], v[184:187]
  v_mfma_f32_16x16x16_bf16 v[188:191], v[126:127], v[24:25], v[188:191]
  s_add_u32 s34, s34, 1
  ds_read_b128 v[20:23], v15 offset:17024
  s_waitcnt lgkmcnt(0)
  v_fma_f32 v28, v20, s39, -v6
  v_fma_f32 v29, v21, s39, -v6
  v_fma_f32 v30, v22, s39, -v6
  v_fma_f32 v31, v23, s39, -v6
  v_exp_f32 v28, v28
  v_exp_f32 v29, v29
  v_exp_f32 v30, v30
  v_exp_f32 v31, v31
  s_nop 0
  v_cvt_pk_bf16_f32 v24, v28, v29
  v_cvt_pk_bf16_f32 v25, v30, v31
  v_add_f32 v8, v28, v29
  v_add_f32 v9, v30, v31
  v_add_f32 v8, v8, v9
  v_add_f32 v7, v7, v8
  s_waitcnt vmcnt(9)
  ds_read_b64_tr_b16 v[96:97], v5 offset:8448
  ds_read_b64_tr_b16 v[98:99], v5 offset:8480
  ds_read_b64_tr_b16 v[100:101], v5 offset:8512
  ds_read_b64_tr_b16 v[102:103], v5 offset:8544
  ds_read_b64_tr_b16 v[104:105], v5 offset:8576
  ds_read_b64_tr_b16 v[106:107], v5 offset:8608
  ds_read_b64_tr_b16 v[108:109], v5 offset:8640
  ds_read_b64_tr_b16 v[110:111], v5 offset:8672
  ds_read_b64_tr_b16 v[112:113], v5 offset:8704
  ds_read_b64_tr_b16 v[114:115], v5 offset:8736
  ds_read_b64_tr_b16 v[116:117], v5 offset:8768
  ds_read_b64_tr_b16 v[118:119], v5 offset:8800
  ds_read_b64_tr_b16 v[120:121], v5 offset:8832
  ds_read_b64_tr_b16 v[122:123], v5 offset:8864
  ds_read_b64_tr_b16 v[124:125], v5 offset:8896
  ds_read_b64_tr_b16 v[126:127], v5 offset:8928
  s_waitcnt lgkmcnt(0)
  s_add_u32 m0, s33, 8448
  v_mfma_f32_16x16x16_bf16 v[128:131], v[96:97], v[24:25], v[128:131]
  buffer_load_dwordx4 v2, s[8:11], s32 offen offset:0 nt lds
  s_add_u32 m0, s33, 8480
  v_mfma_f32_16x16x16_bf16 v[132:135], v[98:99], v[24:25], v[132:135]
  buffer_load_dwordx4 v2, s[8:11], s32 offen offset:1024 nt lds
  s_add_u32 m0, s33, 8512
  v_mfma_f32_16x16x16_bf16 v[136:139], v[100:101], v[24:25], v[136:139]
  buffer_load_dwordx4 v2, s[8:11], s32 offen offset:2048 nt lds
  s_add_u32 m0, s33, 8544
  v_mfma_f32_16x16x16_bf16 v[140:143], v[102:103], v[24:25], v[140:143]
  buffer_load_dwordx4 v2, s[8:11], s32 offen offset:3072 nt lds
  s_add_u32 m0, s33, 12672
  v_mfma_f32_16x16x16_bf16 v[144:147], v[104:105], v[24:25], v[144:147]
  buffer_load_dwordx4 v3, s[8:11], s32 offen offset:0 nt lds
  s_add_u32 m0, s33, 12704
  v_mfma_f32_16x16x16_bf16 v[148:151], v[106:107], v[24:25], v[148:151]
  buffer_load_dwordx4 v3, s[8:11], s32 offen offset:1024 nt lds
  s_add_u32 m0, s33, 12736
  v_mfma_f32_16x16x16_bf16 v[152:155], v[108:109], v[24:25], v[152:155]
  buffer_load_dwordx4 v3, s[8:11], s32 offen offset:2048 nt lds
  s_add_u32 m0, s33, 12768
  v_mfma_f32_16x16x16_bf16 v[156:159], v[110:111], v[24:25], v[156:159]
  buffer_load_dwordx4 v3, s[8:11], s32 offen offset:3072 nt lds
  v_mfma_f32_16x16x16_bf16 v[160:163], v[112:113], v[24:25], v[160:163]
  v_mfma_f32_16x16x16_bf16 v[164:167], v[114:115], v[24:25], v[164:167]
  v_mfma_f32_16x16x16_bf16 v[168:171], v[116:117], v[24:25], v[168:171]
  v_mfma_f32_16x16x16_bf16 v[172:175], v[118:119], v[24:25], v[172:175]
  v_mfma_f32_16x16x16_bf16 v[176:179], v[120:121], v[24:25], v[176:179]
  v_mfma_f32_16x16x16_bf16 v[180:183], v[122:123], v[24:25], v[180:183]
  v_mfma_f32_16x16x16_bf16 v[184:187], v[124:125], v[24:25], v[184:187]
  v_mfma_f32_16x16x16_bf16 v[188:191], v[126:127], v[24:25], v[188:191]
  v_add_u32 v15, 256, v15
  s_add_u32 s34, s34, 1
L_T:
  s_cmp_eq_u32 s41, 0
  s_cbranch_scc1 L_done
  s_waitcnt vmcnt(8)
  ds_read_b128 v[64:67], v4 offset:0
  ds_read_b128 v[68:71], v4 offset:16
  ds_read_b128 v[72:75], v4 offset:32
  ds_read_b128 v[76:79], v4 offset:48
  ds_read_b128 v[80:83], v4 offset:64
  ds_read_b128 v[84:87], v4 offset:80
  ds_read_b128 v[88:91], v4 offset:96
  ds_read_b128 v[92:95], v4 offset:112
  v_readfirstlane_b32 s35, v14
  s_lshl_b32 s35, s35, 2
  s_add_u32 s35, s35, s45
  s_add_u32 s35, s35, 912
  s_or_b32 s35, s35, s40
  s_lshl_b32 s32, s35, 13
  s_add_u32 s32, s32, s31
  s_cmp_lt_u32 s35, 1024
  s_cselect_b32 s32, s32, s42
  s_cselect_b32 s41, 1, 0
  s_cselect_b32 s40, s40, 0x40000000
  s_waitcnt lgkmcnt(0)
  s_cmp_lg_u32 s40, 0
  s_cbranch_scc1 L_dumTa
  v_mov_b32 v14, 1
  s_mov_b64 exec, 1
  buffer_atomic_add v14, v12, s[12:15], s38 offen sc0
  s_mov_b64 exec, -1
  s_branch L_xTa
L_dumTa:
  buffer_load_dword v16, v12, s[16:19], s42 offen
L_xTa:
  s_add_u32 m0, s33, 0
  v_mfma_f32_16x16x32_bf16 v[20:23], v[64:67], v[32:35], 0
  buffer_load_dwordx4 v2, s[4:7], s32 offen offset:0 nt lds
  s_add_u32 m0, s33, 16
  v_mfma_f32_16x16x32_bf16 v[20:23], v[68:71], v[36:39], v[20:23]
  buffer_load_dwordx4 v2, s[4:7], s32 offen offset:1024 nt lds
  s_add_u32 m0, s33, 32
  v_mfma_f32_16x16x32_bf16 v[20:23], v[72:75], v[40:43], v[20:23]
  buffer_load_dwordx4 v2, s[4:7], s32 offen offset:2048 nt lds
  s_add_u32 m0, s33, 48
  v_mfma_f32_16x16x32_bf16 v[20:23], v[76:79], v[44:47], v[20:23]
  buffer_load_dwordx4 v2, s[4:7], s32 offen offset:3072 nt lds
  s_add_u32 m0, s33, 4160
  v_mfma_f32_16x16x32_bf16 v[20:23], v[80:83], v[48:51], v[20:23]
  buffer_load_dwordx4 v3, s[4:7], s32 offen offset:0 nt lds
  s_add_u32 m0, s33, 4176
  v_mfma_f32_16x16x32_bf16 v[20:23], v[84:87], v[52:55], v[20:23]
  buffer_load_dwordx4 v3, s[4:7], s32 offen offset:1024 nt lds
  s_add_u32 m0, s33, 4192
  v_mfma_f32_16x16x32_bf16 v[20:23], v[88:91], v[56:59], v[20:23]
  buffer_load_dwordx4 v3, s[4:7], s32 offen offset:2048 nt lds
  s_add_u32 m0, s33, 4208
  v_mfma_f32_16x16x32_bf16 v[20:23], v[92:95], v[60:63], v[20:23]
  buffer_load_dwordx4 v3, s[4:7], s32 offen offset:3072 nt lds
  s_nop 7
  v_max3_f32 v8, v20, v21, v22
  v_max_f32 v8, v8, v23
  v_mul_f32 v8, s39, v8
  v_cmp_gt_f32 vcc, v8, v6
  s_cbranch_vccz L_nomaxa
  v_mov_b32 v9, v8
  s_nop 1
  v_permlane32_swap_b32 v8, v9
  v_max_f32 v8, v8, v9
  v_mov_b32 v9, v8
  s_nop 1
  v_permlane16_swap_b32 v8, v9
  v_max3_f32 v8, v8, v9, v6
  v_sub_f32 v9, v6, v8
  v_exp_f32 v10, v9
  v_mov_b32 v6, v8
  v_mul_f32 v7, v7, v10
  v_mul_f32 v128, v128, v10
  v_mul_f32 v129, v129, v10
  v_mul_f32 v130, v130, v10
  v_mul_f32 v131, v131, v10
  v_mul_f32 v132, v132, v10
  v_mul_f32 v133, v133, v10
  v_mul_f32 v134, v134, v10
  v_mul_f32 v135, v135, v10
  v_mul_f32 v136, v136, v10
  v_mul_f32 v137, v137, v10
  v_mul_f32 v138, v138, v10
  v_mul_f32 v139, v139, v10
  v_mul_f32 v140, v140, v10
  v_mul_f32 v141, v141, v10
  v_mul_f32 v142, v142, v10
  v_mul_f32 v143, v143, v10
  v_mul_f32 v144, v144, v10
  v_mul_f32 v145, v145, v10
  v_mul_f32 v146, v146, v10
  v_mul_f32 v147, v147, v10
  v_mul_f32 v148, v148, v10
  v_mul_f32 v149, v149, v10
  v_mul_f32 v150, v150, v10
  v_mul_f32 v151, v151, v10
  v_mul_f32 v152, v152, v10
  v_mul_f32 v153, v153, v10
  v_mul_f32 v154, v154, v10
  v_mul_f32 v155, v155, v10
  v_mul_f32 v156, v156, v10
  v_mul_f32 v157, v157, v10
  v_mul_f32 v158, v158, v10
  v_mul_f32 v159, v159, v10
  v_mul_f32 v160, v160, v10
  v_mul_f32 v161, v161, v10
  v_mul_f32 v162, v162, v10
  v_mul_f32 v163, v163, v10
  v_mul_f32 v164, v164, v10
  v_mul_f32 v165, v165, v10
  v_mul_f32 v166, v166, v10
  v_mul_f32 v167, v167, v10
  v_mul_f32 v168, v168, v10
  v_mul_f32 v169, v169, v10
  v_mul_f32 v170, v170, v10
  v_mul_f32 v171, v171, v10
  v_mul_f32 v172, v172, v10
  v_mul_f32 v173, v173, v10
  v_mul_f32 v174, v174, v10
  v_mul_f32 v175, v175, v10
  v_mul_f32 v176, v176, v10
  v_mul_f32 v177, v177, v10
  v_mul_f32 v178, v178, v10
  v_mul_f32 v179, v179, v10
  v_mul_f32 v180, v180, v10
  v_mul_f32 v181, v181, v10
  v_mul_f32 v182, v182, v10
  v_mul_f32 v183, v183, v10
  v_mul_f32 v184, v184, v10
  v_mul_f32 v185, v185, v10
  v_mul_f32 v186, v186, v10
  v_mul_f32 v187, v187, v10
  v_mul_f32 v188, v188, v10
  v_mul_f32 v189, v189, v10
  v_mul_f32 v190, v190, v10
  v_mul_f32 v191, v191, v10
L_nomaxa:
  v_fma_f32 v28, v20, s39, -v6
  v_fma_f32 v29, v21, s39, -v6
  v_fma_f32 v30, v22, s39, -v6
  v_fma_f32 v31, v23, s39, -v6
  v_exp_f32 v28, v28
  v_exp_f32 v29, v29
  v_exp_f32 v30, v30
  v_exp_f32 v31, v31
  s_nop 0
  v_cvt_pk_bf16_f32 v24, v28, v29
  v_cvt_pk_bf16_f32 v25, v30, v31
  v_add_f32 v8, v28, v29
  v_add_f32 v9, v30, v31
  v_add_f32 v8, v8, v9
  v_add_f32 v7, v7, v8
  s_waitcnt vmcnt(9)
  ds_read_b64_tr_b16 v[96:97], v5 offset:8448
  ds_read_b64_tr_b16 v[98:99], v5 offset:8480
  ds_read_b64_tr_b16 v[100:101], v5 offset:8512
  ds_read_b64_tr_b16 v[102:103], v5 offset:8544
  ds_read_b64_tr_b16 v[104:105], v5 offset:8576
  ds_read_b64_tr_b16 v[106:107], v5 offset:8608
  ds_read_b64_tr_b16 v[108:109], v5 offset:8640
  ds_read_b64_tr_b16 v[110:111], v5 offset:8672
  ds_read_b64_tr_b16 v[112:113], v5 offset:8704
  ds_read_b64_tr_b16 v[114:115], v5 offset:8736
  ds_read_b64_tr_b16 v[116:117], v5 offset:8768
  ds_read_b64_tr_b16 v[118:119], v5 offset:8800
  ds_read_b64_tr_b16 v[120:121], v5 offset:8832
  ds_read_b64_tr_b16 v[122:123], v5 offset:8864
  ds_read_b64_tr_b16 v[124:125], v5 offset:8896
  ds_read_b64_tr_b16 v[126:127], v5 offset:8928
  s_waitcnt lgkmcnt(0)
  s_add_u32 m0, s33, 8448
  v_mfma_f32_16x16x16_bf16 v[128:131], v[96:97], v[24:25], v[128:131]
  buffer_load_dwordx4 v2, s[8:11], s32 offen offset:0 nt lds
  s_add_u32 m0, s33, 8480
  v_mfma_f32_16x16x16_bf16 v[132:135], v[98:99], v[24:25], v[132:135]
  buffer_load_dwordx4 v2, s[8:11], s32 offen offset:1024 nt lds
  s_add_u32 m0, s33, 8512
  v_mfma_f32_16x16x16_bf16 v[136:139], v[100:101], v[24:25], v[136:139]
  buffer_load_dwordx4 v2, s[8:11], s32 offen offset:2048 nt lds
  s_add_u32 m0, s33, 8544
  v_mfma_f32_16x16x16_bf16 v[140:143], v[102:103], v[24:25], v[140:143]
  buffer_load_dwordx4 v2, s[8:11], s32 offen offset:3072 nt lds
  s_add_u32 m0, s33, 12672
  v_mfma_f32_16x16x16_bf16 v[144:147], v[104:105], v[24:25], v[144:147]
  buffer_load_dwordx4 v3, s[8:11], s32 offen offset:0 nt lds
  s_add_u32 m0, s33, 12704
  v_mfma_f32_16x16x16_bf16 v[148:151], v[106:107], v[24:25], v[148:151]
  buffer_load_dwordx4 v3, s[8:11], s32 offen offset:1024 nt lds
  s_add_u32 m0, s33, 12736
  v_mfma_f32_16x16x16_bf16 v[152:155], v[108:109], v[24:25], v[152:155]
  buffer_load_dwordx4 v3, s[8:11], s32 offen offset:2048 nt lds
  s_add_u32 m0, s33, 12768
  v_mfma_f32_16x16x16_bf16 v[156:159], v[110:111], v[24:25], v[156:159]
  buffer_load_dwordx4 v3, s[8:11], s32 offen offset:3072 nt lds
  v_mfma_f32_16x16x16_bf16 v[160:163], v[112:113], v[24:25], v[160:163]
  v_mfma_f32_16x16x16_bf16 v[164:167], v[114:115], v[24:25], v[164:167]
  v_mfma_f32_16x16x16_bf16 v[168:171], v[116:117], v[24:25], v[168:171]
  v_mfma_f32_16x16x16_bf16 v[172:175], v[118:119], v[24:25], v[172:175]
  v_mfma_f32_16x16x16_bf16 v[176:179], v[120:121], v[24:25], v[176:179]
  v_mfma_f32_16x16x16_bf16 v[180:183], v[122:123], v[24:25], v[180:183]
  v_mfma_f32_16x16x16_bf16 v[184:187], v[124:125], v[24:25], v[184:187]
  v_mfma_f32_16x16x16_bf16 v[188:191], v[126:127], v[24:25], v[188:191]
  s_add_u32 s34, s34, 1
  s_branch L_T
L_done:
  s_waitcnt vmcnt(0)
  v_mov_b32 v9, v7
  s_nop 1
  v_permlane32_swap_b32 v7, v9
  v_add_f32 v7, v7, v9
  v_mov_b32 v9, v7
  s_nop 1
  v_permlane16_swap_b32 v7, v9
  v_add_f32 v7, v7, v9
  v_and_b32 v8, 15, v1
  v_lshrrev_b32 v9, 4, v1
  v_lshlrev_b32 v10, 10, v8
  v_lshl_add_u32 v10, v9, 4, v10
  v_add_u32 v10, s33, v10
  v_lshlrev_b32 v11, 3, v8
  v_add_u32 v11, s33, v11
  s_mov_b64 exec, s[46:47]
  ds_write_b128 v10, v[128:131] offset:0
  ds_write_b128 v10, v[132:135] offset:64
  ds_write_b128 v10, v[136:139] offset:128
  ds_write_b128 v10, v[140:143] offset:192
  ds_write_b128 v10, v[144:147] offset:256
  ds_write_b128 v10, v[148:151] offset:320
  ds_write_b128 v10, v[152:155] offset:384
  ds_write_b128 v10, v[156:159] offset:448
  ds_write_b128 v10, v[160:163] offset:512
  ds_write_b128 v10, v[164:167] offset:576
  ds_write_b128 v10, v[168:171] offset:640
  ds_write_b128 v10, v[172:175] offset:704
  ds_write_b128 v10, v[176:179] offset:768
  ds_write_b128 v10, v[180:183] offset:832
  ds_write_b128 v10, v[184:187] offset:896
  ds_write_b128 v10, v[188:191] offset:960
  s_mov_b64 exec, 3
  ds_write_b64 v11, v[6:7] offset:2048
  s_mov_b64 exec, -1
  s_waitcnt lgkmcnt(0)
L_bar:
  s_barrier
L_nobar:
  s_cmp_lg_u32 s28, 0
  s_cbranch_scc1 L_end
  v_lshlrev_b32 v8, 5, v1
  v_lshrrev_b32 v9, 5, v1
  v_lshlrev_b32 v9, 3, v9
  ds_read_b64 v[32:33], v9 offset:2048
  ds_read_b128 v[64:67], v8 offset:0
  ds_read_b128 v[68:71], v8 offset:16
  ds_read_b64 v[34:35], v9 offset:23808
  ds_read_b128 v[72:75], v8 offset:21760
  ds_read_b128 v[76:79], v8 offset:21776
  ds_read_b64 v[36:37], v9 offset:45568
  ds_read_b128 v[80:83], v8 offset:43520
  ds_read_b128 v[84:87], v8 offset:43536
  v_add_u32 v10, 65280, v8
  v_add_u32 v11, 65280, v9
  ds_read_b64 v[38:39], v11 offset:2048
  ds_read_b128 v[88:91], v10
  ds_read_b128 v[92:95], v10 offset:16
  s_waitcnt lgkmcnt(0)
  v_max_f32 v56, v32, v34
  v_max_f32 v56, v56, v36
  v_max_f32 v56, v56, v38
  v_sub_f32 v48, v32, v56
  v_sub_f32 v49, v34, v56
  v_sub_f32 v50, v36, v56
  v_sub_f32 v51, v38, v56
  v_exp_f32 v48, v48
  v_exp_f32 v49, v49
  v_exp_f32 v50, v50
  v_exp_f32 v51, v51
  s_nop 0
  v_mul_f32 v57, v48, v33
  v_fmac_f32 v57, v49, v35
  v_fmac_f32 v57, v50, v37
  v_fmac_f32 v57, v51, v39
  v_mul_f32 v128, v48, v64
  v_mul_f32 v129, v48, v65
  v_mul_f32 v130, v48, v66
  v_mul_f32 v131, v48, v67
  v_mul_f32 v132, v48, v68
  v_mul_f32 v133, v48, v69
  v_mul_f32 v134, v48, v70
  v_mul_f32 v135, v48, v71
  v_fmac_f32 v128, v49, v72
  v_fmac_f32 v129, v49, v73
  v_fmac_f32 v130, v49, v74
  v_fmac_f32 v131, v49, v75
  v_fmac_f32 v132, v49, v76
  v_fmac_f32 v133, v49, v77
  v_fmac_f32 v134, v49, v78
  v_fmac_f32 v135, v49, v79
  v_fmac_f32 v128, v50, v80
  v_fmac_f32 v129, v50, v81
  v_fmac_f32 v130, v50, v82
  v_fmac_f32 v131, v50, v83
  v_fmac_f32 v132, v50, v84
  v_fmac_f32 v133, v50, v85
  v_fmac_f32 v134, v50, v86
  v_fmac_f32 v135, v50, v87
  v_fmac_f32 v128, v51, v88
  v_fmac_f32 v129, v51, v89
  v_fmac_f32 v130, v51, v90
  v_fmac_f32 v131, v51, v91
  v_fmac_f32 v132, v51, v92
  v_fmac_f32 v133, v51, v93
  v_fmac_f32 v134, v51, v94
  v_fmac_f32 v135, v51, v95
  s_lshl_b32 s36, s29, 3
  s_add_u32 s36, s36, s30
  s_lshl_b32 s36, s36, 12
  buffer_store_dwordx4 v[128:131], v2, s[12:15], s36 offen sc1
  buffer_store_dwordx4 v[132:135], v2, s[12:15], s36 offen offset:1024 sc1
  s_mov_b32 s62, 1
  s_mov_b32 s63, 1
  s_mov_b64 exec, s[62:63]
  buffer_store_dwordx2 v[56:57], v9, s[12:15], s36 offen offset:2048 sc1
  s_mov_b64 exec, 1
  v_mov_b32 v10, 1
  s_lshl_b32 s36, s29, 2
  s_waitcnt vmcnt(0)
  buffer_atomic_add v10, v12, s[16:19], s36 offen offset:128 sc0
  s_waitcnt vmcnt(0)
  s_mov_b64 exec, -1
  v_readfirstlane_b32 s36, v10
  s_cmp_lg_u32 s36, 5
  s_cbranch_scc1 L_fin
L_poll:
  s_lshl_b32 s36, s29, 15
  buffer_load_dwordx2 v[32:33], v9, s[12:15], s36 offen offset:2048 sc1
  buffer_load_dwordx4 v[64:67], v2, s[12:15], s36 offen sc1
  buffer_load_dwordx4 v[68:71], v2, s[12:15], s36 offen offset:1024 sc1
  s_add_u32 s36, s36, 4096
  buffer_load_dwordx2 v[34:35], v9, s[12:15], s36 offen offset:2048 sc1
  buffer_load_dwordx4 v[72:75], v2, s[12:15], s36 offen sc1
  buffer_load_dwordx4 v[76:79], v2, s[12:15], s36 offen offset:1024 sc1
  s_add_u32 s36, s36, 4096
  buffer_load_dwordx2 v[36:37], v9, s[12:15], s36 offen offset:2048 sc1
  buffer_load_dwordx4 v[80:83], v2, s[12:15], s36 offen sc1
  buffer_load_dwordx4 v[84:87], v2, s[12:15], s36 offen offset:1024 sc1
  s_add_u32 s36, s36, 4096
  buffer_load_dwordx2 v[38:39], v9, s[12:15], s36 offen offset:2048 sc1
  buffer_load_dwordx4 v[88:91], v2, s[12:15], s36 offen sc1
  buffer_load_dwordx4 v[92:95], v2, s[12:15], s36 offen offset:1024 sc1
  s_add_u32 s36, s36, 4096
  buffer_load_dwordx2 v[40:41], v9, s[12:15], s36 offen offset:2048 sc1
  buffer_load_dwordx4 v[96:99], v2, s[12:15], s36 offen sc1
  buffer_load_dwordx4 v[100:103], v2, s[12:15], s36 offen offset:1024 sc1
  s_add_u32 s36, s36, 4096
  buffer_load_dwordx2 v[42:43], v9, s[12:15], s36 offen offset:2048 sc1
  buffer_load_dwordx4 v[104:107], v2, s[12:15], s36 offen sc1
  buffer_load_dwordx4 v[108:111], v2, s[12:15], s36 offen offset:1024 sc1
  s_waitcnt vmcnt(0)
  v_max_f32 v56, v32, v34
  v_max_f32 v56, v56, v36
  v_max_f32 v56, v56, v38
  v_max_f32 v56, v56, v40
  v_max_f32 v56, v56, v42
  v_sub_f32 v48, v32, v56
  v_sub_f32 v49, v34, v56
  v_sub_f32 v50, v36, v56
  v_sub_f32 v51, v38, v56
  v_sub_f32 v52, v40, v56
  v_sub_f32 v53, v42, v56
  v_exp_f32 v48, v48
  v_exp_f32 v49, v49
  v_exp_f32 v50, v50
  v_exp_f32 v51, v51
  v_exp_f32 v52, v52
  v_exp_f32 v53, v53
  s_nop 0
  v_mul_f32 v57, v48, v33
  v_fmac_f32 v57, v49, v35
  v_fmac_f32 v57, v50, v37
  v_fmac_f32 v57, v51, v39
  v_fmac_f32 v57, v52, v41
  v_fmac_f32 v57, v53, v43
  v_mul_f32 v128, v48, v64
  v_mul_f32 v129, v48, v65
  v_mul_f32 v130, v48, v66
  v_mul_f32 v131, v48, v67
  v_mul_f32 v132, v48, v68
  v_mul_f32 v133, v48, v69
  v_mul_f32 v134, v48, v70
  v_mul_f32 v135, v48, v71
  v_fmac_f32 v128, v49, v72
  v_fmac_f32 v129, v49, v73
  v_fmac_f32 v130, v49, v74
  v_fmac_f32 v131, v49, v75
  v_fmac_f32 v132, v49, v76
  v_fmac_f32 v133, v49, v77
  v_fmac_f32 v134, v49, v78
  v_fmac_f32 v135, v49, v79
  v_fmac_f32 v128, v50, v80
  v_fmac_f32 v129, v50, v81
  v_fmac_f32 v130, v50, v82
  v_fmac_f32 v131, v50, v83
  v_fmac_f32 v132, v50, v84
  v_fmac_f32 v133, v50, v85
  v_fmac_f32 v134, v50, v86
  v_fmac_f32 v135, v50, v87
  v_fmac_f32 v128, v51, v88
  v_fmac_f32 v129, v51, v89
  v_fmac_f32 v130, v51, v90
  v_fmac_f32 v131, v51, v91
  v_fmac_f32 v132, v51, v92
  v_fmac_f32 v133, v51, v93
  v_fmac_f32 v134, v51, v94
  v_fmac_f32 v135, v51, v95
  v_fmac_f32 v128, v52, v96
  v_fmac_f32 v129, v52, v97
  v_fmac_f32 v130, v52, v98
  v_fmac_f32 v131, v52, v99
  v_fmac_f32 v132, v52, v100
  v_fmac_f32 v133, v52, v101
  v_fmac_f32 v134, v52, v102
  v_fmac_f32 v135, v52, v103
  v_fmac_f32 v128, v53, v104
  v_fmac_f32 v129, v53, v105
  v_fmac_f32 v130, v53, v106
  v_fmac_f32 v131, v53, v107
  v_fmac_f32 v132, v53, v108
  v_fmac_f32 v133, v53, v109
  v_fmac_f32 v134, v53, v110
  v_fmac_f32 v135, v53, v111
  v_rcp_f32 v57, v57
  s_nop 0
  v_mul_f32 v128, v128, v57
  v_mul_f32 v129, v129, v57
  v_mul_f32 v130, v130, v57
  v_mul_f32 v131, v131, v57
  v_mul_f32 v132, v132, v57
  v_mul_f32 v133, v133, v57
  v_mul_f32 v134, v134, v57
  v_mul_f32 v135, v135, v57
  v_cvt_pk_bf16_f32 v136, v128, v129
  v_cvt_pk_bf16_f32 v137, v130, v131
  v_cvt_pk_bf16_f32 v138, v132, v133
  v_cvt_pk_bf16_f32 v139, v134, v135
  s_lshl_b32 s36, s29, 10
  buffer_store_dwordx4 v[136:139], v2, s[20:23], s36 offen
L_fin:
L_end:
  s_endpgm
.section .rodata,"a"
.p2align 6
.amdhsa_kernel standalone__gqa_softmax__decode_kernel
  .amdhsa_next_free_vgpr 192
  .amdhsa_next_free_sgpr 80
  .amdhsa_accum_offset 192
  .amdhsa_group_segment_fixed_size 0
  .amdhsa_kernarg_size 48
  .amdhsa_user_sgpr_count 2
  .amdhsa_user_sgpr_kernarg_segment_ptr 1
  .amdhsa_system_sgpr_workgroup_id_x 1
.end_amdhsa_kernel
```
